```python
import torch

def _softmax(x, axis=-1):
    return torch.softmax(x, dim=axis)
def _gelu(x):
    return torch.nn.functional.gelu(x, approximate="tanh")
def _silu(x):
    return torch.nn.functional.silu(x)
def _sigmoid(x):
    return torch.sigmoid(x)
def _layernorm(x, axis=-1, eps=1e-5):
    m = x.mean(dim=axis, keepdim=True)
    v = x.var(dim=axis, keepdim=True, unbiased=False)
    return (x - m) / torch.sqrt(v + eps)
def _scatter_add(tgt, idx, src, axis=0):
    return tgt.clone().index_add_(axis, idx, src)
def _segment_sum(src, seg, n):
    out = torch.zeros((n,) + src.shape[1:], dtype=src.dtype)
    return out.index_add_(0, seg, src)
def _pad(x, pw):
    flat = tuple(v for pair in reversed(pw) for v in pair)
    return torch.nn.functional.pad(x, flat)

kernel_name = 'standalone__qk_norm__prompt'

def setup_inputs():

    _w = (lambda a: (lambda t: t.to(torch.bfloat16) if t.is_floating_point() else t)(torch.as_tensor(a)))
    B, H, S, D = 2, 32, 2048, 576
    Dh = D // H
    return {
        "q": _w((lambda *s: torch.randn(*s, dtype=torch.bfloat16) * 0.05)(B, H, S, Dh)),
        "k": _w((lambda *s: torch.randn(*s, dtype=torch.bfloat16) * 0.05)(B, H, S, Dh)),
        "v": _w((lambda *s: torch.randn(*s, dtype=torch.bfloat16) * 0.4)(B, H, S, Dh)),
        "t": _w(torch.abs((lambda *s: torch.randn(*s, dtype=torch.bfloat16) * 0.4)(H)) + 1.0),
    }

def reference(q, k, v, t):
    eps = 1e-6
    qn = q / (torch.sqrt((q * q).sum(axis=-1, keepdims=True)) + eps)
    kn = k / (torch.sqrt((k * k).sum(axis=-1, keepdims=True)) + eps)
    logits = torch.einsum('bhqd,bhkd->bhqk', qn, kn) * t[None, :, None, None]
    attn = _softmax(logits, axis=-1)
    return torch.einsum('bhqk,bhkd->bhqd', attn, v)
```

```asm
; @launch grid=(256,1,1) block=(512,1,1) lds=162304
.amdgcn_target "amdgcn-amd-amdhsa--gfx950"
.text
.globl standalone__qk_norm__prompt_kernel
.p2align 8
.type standalone__qk_norm__prompt_kernel,@function
standalone__qk_norm__prompt_kernel:
    s_cmp_ge_u32 s2, 256
    s_cbranch_scc1 L_end
    s_load_dwordx8 s[40:47], s[0:1], 0
    s_load_dwordx2 s[48:49], s[0:1], 32
    v_lshrrev_b32 v16, 6, v0
    v_and_b32 v1, 63, v0
    v_readfirstlane_b32 s25, v16
    s_getpc_b64 s[62:63]
    v_lshlrev_b32 v16, 7, v1
    v_min_u32 v16, 0x1580, v16
    s_cmp_lg_u32 s25, 7
    s_cbranch_scc1 L_npf
    global_load_dword v31, v16, s[62:63]
L_npf:
    s_lshr_b32 s3, s2, 5
    s_lshl_b32 s3, s3, 3
    s_and_b32 s4, s2, 7
    s_or_b32 s24, s3, s4
    s_bfe_u32 s5, s2, 0x20003
    v_and_b32 v17, 31, v0
    v_lshrrev_b32 v18, 5, v1
    v_mul_u32_u24 v5, 36, v1
    v_mul_u32_u24 v30, 36, v17
    v_lshl_add_u32 v30, v18, 4, v30
    v_lshlrev_b32 v7, 2, v1
    v_add_u32 v8, 152832, v7
    v_mov_b32 v10, 0
    ds_write_b32 v8, v10
    s_mul_i32 s33, s24, 73728
    s_and_b32 s6, s24, 31
    s_lshl_b32 s6, s6, 1
    s_and_b32 s7, s6, 0x3c
    s_mov_b32 s14, 4718592
    s_mov_b32 s15, 0x00020000
    s_mov_b32 s18, 4718592
    s_mov_b32 s19, 0x00020000
    s_and_b32 s50, s25, 3
    s_mul_i32 s37, s50, 2304
    s_add_u32 s36, s33, s37
    s_mul_i32 s5, s5, 18432
    s_add_u32 s32, s36, s5
    s_add_u32 s32, s32, s37
    s_add_u32 s53, s32, 2304
    s_cmp_lt_u32 s25, 4
    s_cselect_b32 s60, s36, s32
    s_cselect_b32 s61, s36, s53
    s_waitcnt lgkmcnt(0)
    s_cselect_b64 s[12:13], s[42:43], s[40:41]
    s_cselect_b64 s[16:17], s[44:45], s[40:41]
    s_barrier
L_nb1:
    s_and_b32 s13, s13, 0xffff
    s_and_b32 s17, s17, 0xffff
    buffer_load_dwordx4 v[64:67], v30, s[12:15], s60 offen
    buffer_load_dwordx4 v[68:71], v30, s[12:15], s60 offen offset:1152
    buffer_load_dword v72, v5, s[12:15], s60 offen offset:32
    buffer_load_dwordx4 v[74:77], v30, s[16:19], s61 offen
    buffer_load_dwordx4 v[78:81], v30, s[16:19], s61 offen offset:1152
    buffer_load_dword v82, v5, s[16:19], s61 offen offset:32
    s_load_dword s29, s[46:47], s7
    v_lshlrev_b32 v6, 4, v1
    v_mov_b32 v11, 0
    v_lshlrev_b32 v19, 3, v18
    v_sub_u32 v19, v17, v19
    v_and_b32 v20, 1, v19
    v_lshlrev_b32 v20, 4, v20
    v_mov_b32 v21, 0x3f80
    v_lshlrev_b32 v20, v20, v21
    v_lshrrev_b32 v19, 1, v19
    v_cmp_eq_u32 vcc, 0, v19
    v_cmp_eq_u32 s[54:55], 8, v19
    s_nop 0
    v_cndmask_b32 v84, 0, v20, vcc
    v_cndmask_b32 v88, 0, v20, s[54:55]
    v_cmp_eq_u32 vcc, 1, v19
    v_cmp_eq_u32 s[54:55], 9, v19
    s_nop 0
    v_cndmask_b32 v85, 0, v20, vcc
    v_cndmask_b32 v89, 0, v20, s[54:55]
    v_cmp_eq_u32 vcc, 2, v19
    v_cmp_eq_u32 s[54:55], 10, v19
    s_nop 0
    v_cndmask_b32 v86, 0, v20, vcc
    v_cndmask_b32 v90, 0, v20, s[54:55]
    v_cmp_eq_u32 vcc, 3, v19
    v_cmp_eq_u32 s[54:55], 11, v19
    s_nop 0
    v_cndmask_b32 v87, 0, v20, vcc
    v_cndmask_b32 v91, 0, v20, s[54:55]
    s_cmp_ge_u32 s25, 4
    s_cbranch_scc1 L_comp
    s_setprio 3
    v_and_b32 v19, 255, v0
    v_mul_u32_u24 v19, 304, v19
    v_mov_b32 v20, 0x3c003c00
    v_mov_b32 v21, 0x3c003c00
    v_mov_b32 v22, 0x3c003c00
    v_mov_b32 v23, 0x3c003c00
    v_add_u32 v19, 74016, v19
    ds_write_b128 v19, v[20:23]
    s_mul_i32 s38, s50, 2432
    s_add_u32 s38, s38, 73728
    v_add_u32 v100, s37, v6
    v_lshrrev_b32 v19, 4, v17
    v_mul_u32_u24 v19, 1216, v19
    v_and_b32 v20, 15, v17
    v_lshl_add_u32 v19, v20, 4, v19
    v_mul_u32_u24 v20, 304, v18
    v_add3_u32 v102, v19, v20, s38
    v_mul_u32_u24 v19, 1216, v18
    v_lshrrev_b32 v20, 4, v17
    v_mul_u32_u24 v20, 608, v20
    v_bfe_u32 v21, v17, 2, 1
    v_mul_u32_u24 v21, 304, v21
    v_add3_u32 v19, v19, v20, v21
    v_and_b32 v20, 3, v17
    v_lshl_add_u32 v19, v20, 1, v19
    v_and_b32 v20, 8, v17
    v_add3_u32 v101, v19, v20, s38
    s_lshl_b32 s51, s50, 2
    s_add_u32 s51, s51, 152832
    v_mov_b32 v103, s51
    v_add_u32 v96, s37, v7
    s_mov_b32 s26, 0
L_ploop:
    s_waitcnt vmcnt(0)
    v_mfma_f32_32x32x16_bf16 v[216:231], v[84:87], v[64:67], 0
    v_mfma_f32_32x32x16_bf16 v[216:231], v[88:91], v[68:71], v[216:231]
    v_mfma_f32_32x32x16_bf16 v[48:63], v[74:77], v[84:87], 0
    v_mfma_f32_32x32x16_bf16 v[48:63], v[78:81], v[88:91], v[48:63]
    v_dot2_f32_bf16 v10, v64, v64, 0
    v_dot2_f32_bf16 v11, v68, v68, 0
    v_dot2_f32_bf16 v14, v72, v72, 0
    v_dot2_f32_bf16 v10, v65, v65, v10
    v_dot2_f32_bf16 v11, v69, v69, v11
    v_dot2_f32_bf16 v10, v66, v66, v10
    v_dot2_f32_bf16 v11, v70, v70, v11
    v_dot2_f32_bf16 v10, v67, v67, v10
    v_dot2_f32_bf16 v11, v71, v71, v11
    v_lshlrev_b32 v92, 16, v72
    v_and_b32 v93, 0xffff0000, v72
    v_lshlrev_b32 v212, 16, v82
    v_and_b32 v213, 0xffff0000, v82
    v_permlane32_swap_b32 v10, v11
    v_add_f32 v14, v14, v10
    v_add_f32 v10, v14, v11
    v_sqrt_f32 v12, v10
    v_sub_f32 v15, v10, v10
    v_add_f32 v12, 0x358637bd, v12
    v_rcp_f32 v12, v12
    v_add_f32 v212, v212, v15
    v_mov_b32 v94, v12
    v_mov_b32 v210, v12
    v_pk_mul_f32 v[92:93], v[92:93], v[12:13] op_sel_hi:[1,0]
    v_cvt_pk_f16_f32 v212, v212, v213
    v_permlane32_swap_b32 v94, v210
    v_cvt_pk_f16_f32 v128, v48, v49
    v_cvt_pk_f16_f32 v129, v50, v51
    v_cvt_pk_f16_f32 v130, v52, v53
    v_cvt_pk_f16_f32 v131, v54, v55
    ds_write_b128 v102, v[128:131] offset:0
    v_cvt_pk_f16_f32 v132, v56, v57
    v_cvt_pk_f16_f32 v133, v58, v59
    v_cvt_pk_f16_f32 v134, v60, v61
    v_cvt_pk_f16_f32 v135, v62, v63
    ds_write_b128 v102, v[132:135] offset:608
    ds_write_b16 v101, v212 offset:256
    ds_write_b16_d16_hi v101, v212 offset:272
    v_cvt_pk_bf16_f32 v144, v92, v93
    v_pk_mul_f32 v[216:217], v[216:217], v[94:95] op_sel_hi:[1,0]
    v_pk_mul_f32 v[218:219], v[218:219], v[94:95] op_sel_hi:[1,0]
    v_pk_mul_f32 v[220:221], v[220:221], v[94:95] op_sel_hi:[1,0]
    v_pk_mul_f32 v[222:223], v[222:223], v[94:95] op_sel_hi:[1,0]
    v_pk_mul_f32 v[224:225], v[224:225], v[210:211] op_sel_hi:[1,0]
    v_pk_mul_f32 v[226:227], v[226:227], v[210:211] op_sel_hi:[1,0]
    v_pk_mul_f32 v[228:229], v[228:229], v[210:211] op_sel_hi:[1,0]
    v_pk_mul_f32 v[230:231], v[230:231], v[210:211] op_sel_hi:[1,0]
    v_cvt_pk_bf16_f32 v136, v216, v217
    v_cvt_pk_bf16_f32 v137, v218, v219
    v_cvt_pk_bf16_f32 v138, v220, v221
    v_cvt_pk_bf16_f32 v139, v222, v223
    v_cvt_pk_bf16_f32 v140, v224, v225
    v_cvt_pk_bf16_f32 v141, v226, v227
    v_cvt_pk_bf16_f32 v142, v228, v229
    v_cvt_pk_bf16_f32 v143, v230, v231
    ds_write_b128 v100, v[136:139]
    ds_write_b128 v100, v[140:143] offset:1024
    ds_write_b32 v96, v144 offset:2048
    v_add_u32 v102, 9728, v102
    v_add_u32 v101, 9728, v101
    s_waitcnt lgkmcnt(0)
    s_mov_b64 exec, 1
    ds_write_b32 v103, v84
    s_mov_b64 exec, -1
    s_cmp_eq_u32 s26, 7
    s_cbranch_scc1 L_pnl
    s_add_u32 s36, s36, 9216
    buffer_load_dwordx4 v[64:67], v30, s[12:15], s36 offen
    buffer_load_dwordx4 v[68:71], v30, s[12:15], s36 offen offset:1152
    buffer_load_dword v72, v5, s[12:15], s36 offen offset:32
    buffer_load_dwordx4 v[74:77], v30, s[16:19], s36 offen
    buffer_load_dwordx4 v[78:81], v30, s[16:19], s36 offen offset:1152
    buffer_load_dword v82, v5, s[16:19], s36 offen offset:32
L_pnl:
    v_add_u32 v100, 9216, v100
    v_add_u32 v96, 9216, v96
    v_add_u32 v103, 16, v103
    s_add_u32 s26, s26, 1
    s_cmp_lt_u32 s26, 8
    s_cbranch_scc1 L_ploop
    s_waitcnt lgkmcnt(0)
    s_endpgm
L_comp:
    v_cmp_gt_u32 vcc, 19, v17
    v_mul_u32_u24 v23, 304, v18
    v_lshl_add_u32 v4, v17, 4, v23
    v_add_u32 v4, 73728, v4
    v_mov_b32 v22, 0x100000
    v_cndmask_b32 v4, v22, v4, vcc
    v_mov_b32 v2, v6
    v_add_u32 v3, 2048, v7
    v_mfma_f32_32x32x4_2b_bf16 v[96:127], v[10:11], v[10:11], 0
    v_mfma_f32_32x32x4_2b_bf16 v[168:199], v[10:11], v[10:11], 0
    v_mfma_f32_32x32x4_2b_bf16 v[128:159], v[10:11], v[10:11], 0
    v_mov_b32 v163, 0x3fc83fcc
    v_mov_b32 v165, 0x3fc83fcc
    v_mov_b32 v160, 0
    v_mov_b32 v161, 0
    s_mov_b32 s8, s40
    s_and_b32 s9, s41, 0xffff
    s_mov_b32 s12, s42
    s_and_b32 s13, s43, 0xffff
    s_mov_b32 s16, s44
    s_and_b32 s17, s45, 0xffff
    s_mov_b32 s20, s48
    s_and_b32 s21, s49, 0xffff
    s_mov_b32 s10, 4718592
    s_mov_b32 s11, 0x00020000
    s_mov_b32 s22, 4718592
    s_mov_b32 s23, 0x00020000
    s_waitcnt lgkmcnt(0)
    s_bitcmp1_b32 s6, 1
    s_cselect_b32 s3, 0, 16
    s_lshl_b32 s29, s29, s3
    s_and_b32 s29, s29, 0xffff0000
    s_and_b32 s3, s29, 0x7fffffff
    v_mov_b32 v26, 0x3fba9a35
    v_mul_f32 v26, s3, v26
    v_mov_b32 v27, 0x3fb8aa3b
    v_mul_f32 v27, s29, v27
    v_readfirstlane_b32 s3, v26
    s_nop 3
    s_lshr_b32 s3, s3, 23
    s_sub_i32 s28, s3, 126
    s_max_i32 s28, s28, -8
    s_sub_i32 s3, 136, s28
    s_lshl_b32 s3, s3, 23
    v_mul_f32 v27, s3, v27
    s_add_i32 s3, s28, 42
    s_mul_i32 s3, s3, 41
    s_and_b32 s3, s3, 63
    s_lshl_b32 s3, s3, 16
    v_readfirstlane_b32 s27, v27
    s_add_u32 s3, s3, 0x4a404a7f
    v_mov_b32 v153, s3
    v_mov_b32 v209, s3
    s_cmp_gt_i32 s28, 2
    s_cbranch_scc1 L_slow
    s_waitcnt vmcnt(3)
    v_mfma_f32_32x32x16_bf16 v[216:231], v[84:87], v[64:67], 0
    v_mfma_f32_32x32x16_bf16 v[216:231], v[88:91], v[68:71], v[216:231]
    v_dot2_f32_bf16 v10, v64, v64, 0
    v_dot2_f32_bf16 v11, v68, v68, 0
    v_dot2_f32_bf16 v14, v72, v72, 0
    v_dot2_f32_bf16 v10, v65, v65, v10
    v_dot2_f32_bf16 v11, v69, v69, v11
    v_dot2_f32_bf16 v10, v66, v66, v10
    v_dot2_f32_bf16 v11, v70, v70, v11
    v_dot2_f32_bf16 v10, v67, v67, v10
    v_dot2_f32_bf16 v11, v71, v71, v11
    v_lshlrev_b32 v92, 16, v72
    v_and_b32 v93, 0xffff0000, v72
    s_nop 1
    v_permlane32_swap_b32 v10, v11
    v_add_f32 v14, v14, v10
    v_add_f32 v10, v14, v11
    v_sqrt_f32 v12, v10
    v_sub_f32 v15, v10, v10
    v_add_f32 v12, 0x358637bd, v12
    v_rcp_f32 v12, v12
    s_nop 0
    v_mul_f32 v12, s27, v12
    v_mov_b32 v94, v12
    v_mov_b32 v210, v12
    v_pk_mul_f32 v[92:93], v[92:93], v[12:13] op_sel_hi:[1,0]
    s_nop 0
    v_permlane32_swap_b32 v94, v210
    v_cvt_pk_bf16_f32 v152, v92, v93
    v_pk_mul_f32 v[216:217], v[216:217], v[94:95] op_sel_hi:[1,0]
    v_pk_mul_f32 v[218:219], v[218:219], v[94:95] op_sel_hi:[1,0]
    v_pk_mul_f32 v[220:221], v[220:221], v[94:95] op_sel_hi:[1,0]
    v_pk_mul_f32 v[222:223], v[222:223], v[94:95] op_sel_hi:[1,0]
    v_pk_mul_f32 v[224:225], v[224:225], v[210:211] op_sel_hi:[1,0]
    v_pk_mul_f32 v[226:227], v[226:227], v[210:211] op_sel_hi:[1,0]
    v_pk_mul_f32 v[228:229], v[228:229], v[210:211] op_sel_hi:[1,0]
    v_pk_mul_f32 v[230:231], v[230:231], v[210:211] op_sel_hi:[1,0]
    v_cvt_pk_bf16_f32 v144, v216, v217
    v_cvt_pk_bf16_f32 v145, v218, v219
    v_cvt_pk_bf16_f32 v146, v220, v221
    v_cvt_pk_bf16_f32 v147, v222, v223
    v_cvt_pk_bf16_f32 v148, v224, v225
    v_cvt_pk_bf16_f32 v149, v226, v227
    v_cvt_pk_bf16_f32 v150, v228, v229
    v_cvt_pk_bf16_f32 v151, v230, v231
L_w0:
    ds_read_b32 v13, v8
    s_waitcnt lgkmcnt(0)
    v_cmp_eq_u32 vcc, 0, v13
    s_nop 1
    s_and_b32 s3, vcc_lo, 7
    s_cbranch_scc0 L_go
    s_sleep 1
    s_branch L_w0
L_go:
    ds_read_b128 v[20:23], v2
    ds_read_b32 v162, v3
    ds_read_b128 v[24:27], v4
    ds_read_b128 v[16:19], v2 offset:1024
    s_mov_b32 s26, 0
    s_mov_b32 s34, 1
    s_waitcnt lgkmcnt(0)
    v_mfma_f32_32x32x16_bf16 v[32:47], v[20:23], v[144:147], 0
    v_mfma_f32_32x32x16_bf16 v[48:63], v[20:23], v[148:151], 0
    v_or3_b32 v13, v24, v25, v26
    v_or_b32 v13, v13, v27
    v_and_b32 v13, 0x60006000, v13
    v_cmp_ne_u32 vcc, 0, v13
    s_mov_b32 s4, 0xfffbffff
    s_mov_b32 s5, s4
    s_and_b64 s[4:5], s[4:5], vcc
    s_cbranch_scc0 L_slow
    s_waitcnt vmcnt(0)
    v_mov_b32 v28, 0
    v_mov_b32 v29, 0
    v_mov_b32 v30, 0
    v_mov_b32 v31, 0
    v_mfma_f32_32x32x16_bf16 v[216:231], v[84:87], v[74:77], 0
    v_mfma_f32_32x32x16_bf16 v[216:231], v[88:91], v[78:81], v[216:231]
    v_dot2_f32_bf16 v10, v74, v74, 0
    v_dot2_f32_bf16 v11, v78, v78, 0
    v_dot2_f32_bf16 v14, v82, v82, 0
    v_dot2_f32_bf16 v10, v75, v75, v10
    v_dot2_f32_bf16 v11, v79, v79, v11
    v_dot2_f32_bf16 v10, v76, v76, v10
    v_dot2_f32_bf16 v11, v80, v80, v11
    v_dot2_f32_bf16 v10, v77, v77, v10
    v_dot2_f32_bf16 v11, v81, v81, v11
    v_lshlrev_b32 v92, 16, v82
    v_and_b32 v93, 0xffff0000, v82
    s_nop 1
    v_mfma_f32_32x32x4_2b_bf16 v[32:63], v[162:163], v[152:153], v[32:63] cbsz:1 abid:0
    v_permlane32_swap_b32 v10, v11
    v_add_f32 v14, v14, v10
    v_add_f32 v10, v14, v11
    v_sqrt_f32 v12, v10
    v_sub_f32 v9, v10, v10
    v_add_f32 v12, 0x358637bd, v12
    v_rcp_f32 v12, v12
    s_nop 0
    v_mul_f32 v12, s27, v12
    v_mov_b32 v94, v12
    v_mov_b32 v210, v12
    v_pk_mul_f32 v[92:93], v[92:93], v[12:13] op_sel_hi:[1,0]
    s_nop 0
    v_permlane32_swap_b32 v94, v210
    v_cvt_pk_bf16_f32 v208, v92, v93
    v_pk_mul_f32 v[216:217], v[216:217], v[94:95] op_sel_hi:[1,0]
    v_pk_mul_f32 v[218:219], v[218:219], v[94:95] op_sel_hi:[1,0]
    v_pk_mul_f32 v[220:221], v[220:221], v[94:95] op_sel_hi:[1,0]
    v_pk_mul_f32 v[222:223], v[222:223], v[94:95] op_sel_hi:[1,0]
    v_pk_mul_f32 v[224:225], v[224:225], v[210:211] op_sel_hi:[1,0]
    v_pk_mul_f32 v[226:227], v[226:227], v[210:211] op_sel_hi:[1,0]
    v_pk_mul_f32 v[228:229], v[228:229], v[210:211] op_sel_hi:[1,0]
    v_pk_mul_f32 v[230:231], v[230:231], v[210:211] op_sel_hi:[1,0]
    v_cvt_pk_bf16_f32 v200, v216, v217
    v_cvt_pk_bf16_f32 v201, v218, v219
    v_cvt_pk_bf16_f32 v202, v220, v221
    v_cvt_pk_bf16_f32 v203, v222, v223
    v_cvt_pk_bf16_f32 v204, v224, v225
    v_cvt_pk_bf16_f32 v205, v226, v227
    v_cvt_pk_bf16_f32 v206, v228, v229
    v_cvt_pk_bf16_f32 v207, v230, v231
.p2align 6
L_loop:
    v_mfma_f32_32x32x16_f16 v[168:183], v[28:31], v[128:131], v[168:183]
    ds_read_b128 v[154:157], v4 offset:608
    v_exp_f16 v128, v32
    v_exp_f16 v129, v34
    v_exp_f16 v130, v36
    v_mfma_f32_32x32x16_bf16 v[64:79], v[20:23], v[200:203], 0
    v_exp_f16 v131, v38
    v_exp_f16_sdwa v128, v33 dst_sel:WORD_1 dst_unused:UNUSED_PRESERVE src0_sel:WORD_0
    v_exp_f16_sdwa v129, v35 dst_sel:WORD_1 dst_unused:UNUSED_PRESERVE src0_sel:WORD_0
    v_mfma_f32_32x32x16_f16 v[184:199], v[28:31], v[136:139], v[184:199]
    v_exp_f16_sdwa v130, v37 dst_sel:WORD_1 dst_unused:UNUSED_PRESERVE src0_sel:WORD_0
    v_exp_f16_sdwa v131, v39 dst_sel:WORD_1 dst_unused:UNUSED_PRESERVE src0_sel:WORD_0
    v_exp_f16 v136, v48
    v_mfma_f32_32x32x16_bf16 v[80:95], v[20:23], v[204:207], 0
    v_exp_f16 v137, v50
    v_exp_f16 v138, v52
    v_exp_f16 v139, v54
    v_mfma_f32_32x32x16_f16 v[168:183], v[158:161], v[132:135], v[168:183]
    v_exp_f16_sdwa v136, v49 dst_sel:WORD_1 dst_unused:UNUSED_PRESERVE src0_sel:WORD_0
    v_exp_f16_sdwa v137, v51 dst_sel:WORD_1 dst_unused:UNUSED_PRESERVE src0_sel:WORD_0
    v_exp_f16_sdwa v138, v53 dst_sel:WORD_1 dst_unused:UNUSED_PRESERVE src0_sel:WORD_0
    v_exp_f16_sdwa v139, v55 dst_sel:WORD_1 dst_unused:UNUSED_PRESERVE src0_sel:WORD_0
    v_mfma_f32_32x32x4_2b_bf16 v[64:95], v[162:163], v[208:209], v[64:95] cbsz:1 abid:0
    v_exp_f16 v132, v40
    v_exp_f16 v133, v42
    v_exp_f16 v134, v44
    v_exp_f16 v135, v46
    v_exp_f16_sdwa v132, v41 dst_sel:WORD_1 dst_unused:UNUSED_PRESERVE src0_sel:WORD_0
    v_exp_f16_sdwa v133, v43 dst_sel:WORD_1 dst_unused:UNUSED_PRESERVE src0_sel:WORD_0
    v_exp_f16_sdwa v134, v45 dst_sel:WORD_1 dst_unused:UNUSED_PRESERVE src0_sel:WORD_0
    v_exp_f16_sdwa v135, v47 dst_sel:WORD_1 dst_unused:UNUSED_PRESERVE src0_sel:WORD_0
    v_mfma_f32_32x32x16_f16 v[184:199], v[158:161], v[140:143], v[184:199]
    s_waitcnt lgkmcnt(0)
    v_exp_f16 v140, v56
    v_exp_f16 v141, v58
    v_exp_f16 v142, v60
    v_exp_f16 v143, v62
    v_exp_f16_sdwa v140, v57 dst_sel:WORD_1 dst_unused:UNUSED_PRESERVE src0_sel:WORD_0
    v_exp_f16_sdwa v141, v59 dst_sel:WORD_1 dst_unused:UNUSED_PRESERVE src0_sel:WORD_0
    v_exp_f16_sdwa v142, v61 dst_sel:WORD_1 dst_unused:UNUSED_PRESERVE src0_sel:WORD_0
    v_exp_f16_sdwa v143, v63 dst_sel:WORD_1 dst_unused:UNUSED_PRESERVE src0_sel:WORD_0
    v_mfma_f32_32x32x16_f16 v[96:111], v[24:27], v[128:131], v[96:111]
    ds_read_b128 v[20:23], v2 offset:2304
    v_exp_f16 v128, v64
    v_exp_f16 v129, v66
    v_exp_f16 v130, v68
    v_mfma_f32_32x32x16_bf16 v[32:47], v[16:19], v[144:147], 0
    ds_read_b128 v[28:31], v4 offset:1216
    v_exp_f16 v131, v70
    v_exp_f16_sdwa v128, v65 dst_sel:WORD_1 dst_unused:UNUSED_PRESERVE src0_sel:WORD_0
    v_exp_f16_sdwa v129, v67 dst_sel:WORD_1 dst_unused:UNUSED_PRESERVE src0_sel:WORD_0
    v_mfma_f32_32x32x16_f16 v[112:127], v[24:27], v[136:139], v[112:127]
    v_exp_f16_sdwa v130, v69 dst_sel:WORD_1 dst_unused:UNUSED_PRESERVE src0_sel:WORD_0
    v_exp_f16_sdwa v131, v71 dst_sel:WORD_1 dst_unused:UNUSED_PRESERVE src0_sel:WORD_0
    v_exp_f16 v136, v80
    v_mfma_f32_32x32x16_bf16 v[48:63], v[16:19], v[148:151], 0
    v_exp_f16 v137, v82
    v_exp_f16 v138, v84
    v_exp_f16 v139, v86
    v_mfma_f32_32x32x16_f16 v[96:111], v[154:157], v[132:135], v[96:111]
    v_exp_f16_sdwa v136, v81 dst_sel:WORD_1 dst_unused:UNUSED_PRESERVE src0_sel:WORD_0
    v_exp_f16_sdwa v137, v83 dst_sel:WORD_1 dst_unused:UNUSED_PRESERVE src0_sel:WORD_0
    v_exp_f16_sdwa v138, v85 dst_sel:WORD_1 dst_unused:UNUSED_PRESERVE src0_sel:WORD_0
    v_exp_f16_sdwa v139, v87 dst_sel:WORD_1 dst_unused:UNUSED_PRESERVE src0_sel:WORD_0
    v_mfma_f32_32x32x4_2b_bf16 v[32:63], v[162:163], v[152:153], v[32:63] cbsz:1 abid:1
    v_exp_f16 v132, v72
    v_exp_f16 v133, v74
    v_exp_f16 v134, v76
    v_exp_f16 v135, v78
    v_exp_f16_sdwa v132, v73 dst_sel:WORD_1 dst_unused:UNUSED_PRESERVE src0_sel:WORD_0
    v_exp_f16_sdwa v133, v75 dst_sel:WORD_1 dst_unused:UNUSED_PRESERVE src0_sel:WORD_0
    v_exp_f16_sdwa v134, v77 dst_sel:WORD_1 dst_unused:UNUSED_PRESERVE src0_sel:WORD_0
    v_exp_f16_sdwa v135, v79 dst_sel:WORD_1 dst_unused:UNUSED_PRESERVE src0_sel:WORD_0
    v_mfma_f32_32x32x16_f16 v[112:127], v[154:157], v[140:143], v[112:127]
    v_exp_f16 v140, v88
    v_exp_f16 v141, v90
    v_exp_f16 v142, v92
    v_exp_f16 v143, v94
    v_exp_f16_sdwa v140, v89 dst_sel:WORD_1 dst_unused:UNUSED_PRESERVE src0_sel:WORD_0
    v_exp_f16_sdwa v141, v91 dst_sel:WORD_1 dst_unused:UNUSED_PRESERVE src0_sel:WORD_0
    v_exp_f16_sdwa v142, v93 dst_sel:WORD_1 dst_unused:UNUSED_PRESERVE src0_sel:WORD_0
    v_exp_f16_sdwa v143, v95 dst_sel:WORD_1 dst_unused:UNUSED_PRESERVE src0_sel:WORD_0
    v_mfma_f32_32x32x16_f16 v[168:183], v[24:27], v[128:131], v[168:183]
    ds_read_b128 v[158:161], v4 offset:1824
    v_exp_f16 v128, v32
    v_exp_f16 v129, v34
    v_exp_f16 v130, v36
    v_mfma_f32_32x32x16_bf16 v[64:79], v[16:19], v[200:203], 0
    ds_read_b32 v164, v3 offset:2304
    v_exp_f16 v131, v38
    v_exp_f16_sdwa v128, v33 dst_sel:WORD_1 dst_unused:UNUSED_PRESERVE src0_sel:WORD_0
    v_exp_f16_sdwa v129, v35 dst_sel:WORD_1 dst_unused:UNUSED_PRESERVE src0_sel:WORD_0
    v_mfma_f32_32x32x16_f16 v[184:199], v[24:27], v[136:139], v[184:199]
    v_exp_f16_sdwa v130, v37 dst_sel:WORD_1 dst_unused:UNUSED_PRESERVE src0_sel:WORD_0
    v_exp_f16_sdwa v131, v39 dst_sel:WORD_1 dst_unused:UNUSED_PRESERVE src0_sel:WORD_0
    v_exp_f16 v136, v48
    v_mfma_f32_32x32x16_bf16 v[80:95], v[16:19], v[204:207], 0
    v_exp_f16 v137, v50
    v_exp_f16 v138, v52
    v_exp_f16 v139, v54
    v_mfma_f32_32x32x16_f16 v[168:183], v[154:157], v[132:135], v[168:183]
    v_exp_f16_sdwa v136, v49 dst_sel:WORD_1 dst_unused:UNUSED_PRESERVE src0_sel:WORD_0
    v_exp_f16_sdwa v137, v51 dst_sel:WORD_1 dst_unused:UNUSED_PRESERVE src0_sel:WORD_0
    v_exp_f16_sdwa v138, v53 dst_sel:WORD_1 dst_unused:UNUSED_PRESERVE src0_sel:WORD_0
    v_exp_f16_sdwa v139, v55 dst_sel:WORD_1 dst_unused:UNUSED_PRESERVE src0_sel:WORD_0
    v_mfma_f32_32x32x4_2b_bf16 v[64:95], v[162:163], v[208:209], v[64:95] cbsz:1 abid:1
    v_exp_f16 v132, v40
    v_exp_f16 v133, v42
    v_exp_f16 v134, v44
    v_exp_f16 v135, v46
    v_exp_f16_sdwa v132, v41 dst_sel:WORD_1 dst_unused:UNUSED_PRESERVE src0_sel:WORD_0
    v_exp_f16_sdwa v133, v43 dst_sel:WORD_1 dst_unused:UNUSED_PRESERVE src0_sel:WORD_0
    v_exp_f16_sdwa v134, v45 dst_sel:WORD_1 dst_unused:UNUSED_PRESERVE src0_sel:WORD_0
    v_exp_f16_sdwa v135, v47 dst_sel:WORD_1 dst_unused:UNUSED_PRESERVE src0_sel:WORD_0
    v_mfma_f32_32x32x16_f16 v[184:199], v[154:157], v[140:143], v[184:199]
    s_waitcnt lgkmcnt(0)
    v_exp_f16 v140, v56
    v_exp_f16 v141, v58
    v_exp_f16 v142, v60
    v_exp_f16 v143, v62
    v_exp_f16_sdwa v140, v57 dst_sel:WORD_1 dst_unused:UNUSED_PRESERVE src0_sel:WORD_0
    v_exp_f16_sdwa v141, v59 dst_sel:WORD_1 dst_unused:UNUSED_PRESERVE src0_sel:WORD_0
    v_exp_f16_sdwa v142, v61 dst_sel:WORD_1 dst_unused:UNUSED_PRESERVE src0_sel:WORD_0
    v_exp_f16_sdwa v143, v63 dst_sel:WORD_1 dst_unused:UNUSED_PRESERVE src0_sel:WORD_0
    v_mfma_f32_32x32x16_f16 v[96:111], v[28:31], v[128:131], v[96:111]
    ds_read_b128 v[16:19], v2 offset:3328
    v_exp_f16 v128, v64
    v_exp_f16 v129, v66
    v_exp_f16 v130, v68
    v_mfma_f32_32x32x16_bf16 v[32:47], v[20:23], v[144:147], 0
    ds_read_b128 v[24:27], v4 offset:2432
    v_exp_f16 v131, v70
    v_exp_f16_sdwa v128, v65 dst_sel:WORD_1 dst_unused:UNUSED_PRESERVE src0_sel:WORD_0
    v_exp_f16_sdwa v129, v67 dst_sel:WORD_1 dst_unused:UNUSED_PRESERVE src0_sel:WORD_0
    v_mfma_f32_32x32x16_f16 v[112:127], v[28:31], v[136:139], v[112:127]
    v_exp_f16_sdwa v130, v69 dst_sel:WORD_1 dst_unused:UNUSED_PRESERVE src0_sel:WORD_0
    v_exp_f16_sdwa v131, v71 dst_sel:WORD_1 dst_unused:UNUSED_PRESERVE src0_sel:WORD_0
    v_exp_f16 v136, v80
    v_mfma_f32_32x32x16_bf16 v[48:63], v[20:23], v[148:151], 0
    v_exp_f16 v137, v82
    v_exp_f16 v138, v84
    v_exp_f16 v139, v86
    v_mfma_f32_32x32x16_f16 v[96:111], v[158:161], v[132:135], v[96:111]
    v_exp_f16_sdwa v136, v81 dst_sel:WORD_1 dst_unused:UNUSED_PRESERVE src0_sel:WORD_0
    v_exp_f16_sdwa v137, v83 dst_sel:WORD_1 dst_unused:UNUSED_PRESERVE src0_sel:WORD_0
    v_exp_f16_sdwa v138, v85 dst_sel:WORD_1 dst_unused:UNUSED_PRESERVE src0_sel:WORD_0
    v_exp_f16_sdwa v139, v87 dst_sel:WORD_1 dst_unused:UNUSED_PRESERVE src0_sel:WORD_0
    v_mfma_f32_32x32x4_2b_bf16 v[32:63], v[164:165], v[152:153], v[32:63] cbsz:1 abid:0
    v_exp_f16 v132, v72
    v_exp_f16 v133, v74
    v_exp_f16 v134, v76
    v_exp_f16 v135, v78
    v_exp_f16_sdwa v132, v73 dst_sel:WORD_1 dst_unused:UNUSED_PRESERVE src0_sel:WORD_0
    v_exp_f16_sdwa v133, v75 dst_sel:WORD_1 dst_unused:UNUSED_PRESERVE src0_sel:WORD_0
    v_exp_f16_sdwa v134, v77 dst_sel:WORD_1 dst_unused:UNUSED_PRESERVE src0_sel:WORD_0
    v_exp_f16_sdwa v135, v79 dst_sel:WORD_1 dst_unused:UNUSED_PRESERVE src0_sel:WORD_0
    v_mfma_f32_32x32x16_f16 v[112:127], v[158:161], v[140:143], v[112:127]
    v_exp_f16 v140, v88
    v_exp_f16 v141, v90
    v_exp_f16 v142, v92
    v_exp_f16 v143, v94
    v_exp_f16_sdwa v140, v89 dst_sel:WORD_1 dst_unused:UNUSED_PRESERVE src0_sel:WORD_0
    v_exp_f16_sdwa v141, v91 dst_sel:WORD_1 dst_unused:UNUSED_PRESERVE src0_sel:WORD_0
    v_exp_f16_sdwa v142, v93 dst_sel:WORD_1 dst_unused:UNUSED_PRESERVE src0_sel:WORD_0
    v_exp_f16_sdwa v143, v95 dst_sel:WORD_1 dst_unused:UNUSED_PRESERVE src0_sel:WORD_0
    v_mfma_f32_32x32x16_f16 v[168:183], v[28:31], v[128:131], v[168:183]
    ds_read_b128 v[154:157], v4 offset:3040
    v_exp_f16 v128, v32
    v_exp_f16 v129, v34
    v_exp_f16 v130, v36
    v_mfma_f32_32x32x16_bf16 v[64:79], v[20:23], v[200:203], 0
    v_exp_f16 v131, v38
    v_exp_f16_sdwa v128, v33 dst_sel:WORD_1 dst_unused:UNUSED_PRESERVE src0_sel:WORD_0
    v_exp_f16_sdwa v129, v35 dst_sel:WORD_1 dst_unused:UNUSED_PRESERVE src0_sel:WORD_0
    v_mfma_f32_32x32x16_f16 v[184:199], v[28:31], v[136:139], v[184:199]
    v_exp_f16_sdwa v130, v37 dst_sel:WORD_1 dst_unused:UNUSED_PRESERVE src0_sel:WORD_0
    v_exp_f16_sdwa v131, v39 dst_sel:WORD_1 dst_unused:UNUSED_PRESERVE src0_sel:WORD_0
    v_exp_f16 v136, v48
    v_mfma_f32_32x32x16_bf16 v[80:95], v[20:23], v[204:207], 0
    v_exp_f16 v137, v50
    v_exp_f16 v138, v52
    v_exp_f16 v139, v54
    v_mfma_f32_32x32x16_f16 v[168:183], v[158:161], v[132:135], v[168:183]
    v_exp_f16_sdwa v136, v49 dst_sel:WORD_1 dst_unused:UNUSED_PRESERVE src0_sel:WORD_0
    v_exp_f16_sdwa v137, v51 dst_sel:WORD_1 dst_unused:UNUSED_PRESERVE src0_sel:WORD_0
    v_exp_f16_sdwa v138, v53 dst_sel:WORD_1 dst_unused:UNUSED_PRESERVE src0_sel:WORD_0
    v_exp_f16_sdwa v139, v55 dst_sel:WORD_1 dst_unused:UNUSED_PRESERVE src0_sel:WORD_0
    v_mfma_f32_32x32x4_2b_bf16 v[64:95], v[164:165], v[208:209], v[64:95] cbsz:1 abid:0
    v_exp_f16 v132, v40
    v_exp_f16 v133, v42
    v_exp_f16 v134, v44
    v_exp_f16 v135, v46
    v_exp_f16_sdwa v132, v41 dst_sel:WORD_1 dst_unused:UNUSED_PRESERVE src0_sel:WORD_0
    v_exp_f16_sdwa v133, v43 dst_sel:WORD_1 dst_unused:UNUSED_PRESERVE src0_sel:WORD_0
    v_exp_f16_sdwa v134, v45 dst_sel:WORD_1 dst_unused:UNUSED_PRESERVE src0_sel:WORD_0
    v_exp_f16_sdwa v135, v47 dst_sel:WORD_1 dst_unused:UNUSED_PRESERVE src0_sel:WORD_0
    v_mfma_f32_32x32x16_f16 v[184:199], v[158:161], v[140:143], v[184:199]
    s_waitcnt lgkmcnt(0)
    v_exp_f16 v140, v56
    v_exp_f16 v141, v58
    v_exp_f16 v142, v60
    v_exp_f16 v143, v62
    v_exp_f16_sdwa v140, v57 dst_sel:WORD_1 dst_unused:UNUSED_PRESERVE src0_sel:WORD_0
    v_exp_f16_sdwa v141, v59 dst_sel:WORD_1 dst_unused:UNUSED_PRESERVE src0_sel:WORD_0
    v_exp_f16_sdwa v142, v61 dst_sel:WORD_1 dst_unused:UNUSED_PRESERVE src0_sel:WORD_0
    v_exp_f16_sdwa v143, v63 dst_sel:WORD_1 dst_unused:UNUSED_PRESERVE src0_sel:WORD_0
    v_mfma_f32_32x32x16_f16 v[96:111], v[24:27], v[128:131], v[96:111]
    ds_read_b128 v[20:23], v2 offset:4608
    v_exp_f16 v128, v64
    v_exp_f16 v129, v66
    v_exp_f16 v130, v68
    v_mfma_f32_32x32x16_bf16 v[32:47], v[16:19], v[144:147], 0
    ds_read_b128 v[28:31], v4 offset:3648
    v_exp_f16 v131, v70
    v_exp_f16_sdwa v128, v65 dst_sel:WORD_1 dst_unused:UNUSED_PRESERVE src0_sel:WORD_0
    v_exp_f16_sdwa v129, v67 dst_sel:WORD_1 dst_unused:UNUSED_PRESERVE src0_sel:WORD_0
    v_mfma_f32_32x32x16_f16 v[112:127], v[24:27], v[136:139], v[112:127]
    v_exp_f16_sdwa v130, v69 dst_sel:WORD_1 dst_unused:UNUSED_PRESERVE src0_sel:WORD_0
    v_exp_f16_sdwa v131, v71 dst_sel:WORD_1 dst_unused:UNUSED_PRESERVE src0_sel:WORD_0
    v_exp_f16 v136, v80
    v_mfma_f32_32x32x16_bf16 v[48:63], v[16:19], v[148:151], 0
    v_exp_f16 v137, v82
    v_exp_f16 v138, v84
    v_exp_f16 v139, v86
    v_mfma_f32_32x32x16_f16 v[96:111], v[154:157], v[132:135], v[96:111]
    v_exp_f16_sdwa v136, v81 dst_sel:WORD_1 dst_unused:UNUSED_PRESERVE src0_sel:WORD_0
    v_exp_f16_sdwa v137, v83 dst_sel:WORD_1 dst_unused:UNUSED_PRESERVE src0_sel:WORD_0
    v_exp_f16_sdwa v138, v85 dst_sel:WORD_1 dst_unused:UNUSED_PRESERVE src0_sel:WORD_0
    v_exp_f16_sdwa v139, v87 dst_sel:WORD_1 dst_unused:UNUSED_PRESERVE src0_sel:WORD_0
    v_mfma_f32_32x32x4_2b_bf16 v[32:63], v[164:165], v[152:153], v[32:63] cbsz:1 abid:1
    v_exp_f16 v132, v72
    v_exp_f16 v133, v74
    v_exp_f16 v134, v76
    v_exp_f16 v135, v78
    v_exp_f16_sdwa v132, v73 dst_sel:WORD_1 dst_unused:UNUSED_PRESERVE src0_sel:WORD_0
    v_exp_f16_sdwa v133, v75 dst_sel:WORD_1 dst_unused:UNUSED_PRESERVE src0_sel:WORD_0
    v_exp_f16_sdwa v134, v77 dst_sel:WORD_1 dst_unused:UNUSED_PRESERVE src0_sel:WORD_0
    v_exp_f16_sdwa v135, v79 dst_sel:WORD_1 dst_unused:UNUSED_PRESERVE src0_sel:WORD_0
    v_mfma_f32_32x32x16_f16 v[112:127], v[154:157], v[140:143], v[112:127]
    v_exp_f16 v140, v88
    v_exp_f16 v141, v90
    v_exp_f16 v142, v92
    v_exp_f16 v143, v94
    v_exp_f16_sdwa v140, v89 dst_sel:WORD_1 dst_unused:UNUSED_PRESERVE src0_sel:WORD_0
    v_exp_f16_sdwa v141, v91 dst_sel:WORD_1 dst_unused:UNUSED_PRESERVE src0_sel:WORD_0
    v_exp_f16_sdwa v142, v93 dst_sel:WORD_1 dst_unused:UNUSED_PRESERVE src0_sel:WORD_0
    v_exp_f16_sdwa v143, v95 dst_sel:WORD_1 dst_unused:UNUSED_PRESERVE src0_sel:WORD_0
    v_mfma_f32_32x32x16_f16 v[168:183], v[24:27], v[128:131], v[168:183]
    ds_read_b128 v[158:161], v4 offset:4256
    v_exp_f16 v128, v32
    v_exp_f16 v129, v34
    v_exp_f16 v130, v36
    v_mfma_f32_32x32x16_bf16 v[64:79], v[16:19], v[200:203], 0
    ds_read_b32 v162, v3 offset:4608
    v_exp_f16 v131, v38
    v_exp_f16_sdwa v128, v33 dst_sel:WORD_1 dst_unused:UNUSED_PRESERVE src0_sel:WORD_0
    v_exp_f16_sdwa v129, v35 dst_sel:WORD_1 dst_unused:UNUSED_PRESERVE src0_sel:WORD_0
    v_mfma_f32_32x32x16_f16 v[184:199], v[24:27], v[136:139], v[184:199]
    ds_read_b32 v13, v8
    v_exp_f16_sdwa v130, v37 dst_sel:WORD_1 dst_unused:UNUSED_PRESERVE src0_sel:WORD_0
    v_exp_f16_sdwa v131, v39 dst_sel:WORD_1 dst_unused:UNUSED_PRESERVE src0_sel:WORD_0
    v_exp_f16 v136, v48
    v_mfma_f32_32x32x16_bf16 v[80:95], v[16:19], v[204:207], 0
    v_exp_f16 v137, v50
    v_exp_f16 v138, v52
    v_exp_f16 v139, v54
    v_mfma_f32_32x32x16_f16 v[168:183], v[154:157], v[132:135], v[168:183]
    v_exp_f16_sdwa v136, v49 dst_sel:WORD_1 dst_unused:UNUSED_PRESERVE src0_sel:WORD_0
    v_exp_f16_sdwa v137, v51 dst_sel:WORD_1 dst_unused:UNUSED_PRESERVE src0_sel:WORD_0
    v_exp_f16_sdwa v138, v53 dst_sel:WORD_1 dst_unused:UNUSED_PRESERVE src0_sel:WORD_0
    v_exp_f16_sdwa v139, v55 dst_sel:WORD_1 dst_unused:UNUSED_PRESERVE src0_sel:WORD_0
    v_mfma_f32_32x32x4_2b_bf16 v[64:95], v[164:165], v[208:209], v[64:95] cbsz:1 abid:1
    v_exp_f16 v132, v40
    v_exp_f16 v133, v42
    v_exp_f16 v134, v44
    v_exp_f16 v135, v46
    v_exp_f16_sdwa v132, v41 dst_sel:WORD_1 dst_unused:UNUSED_PRESERVE src0_sel:WORD_0
    v_exp_f16_sdwa v133, v43 dst_sel:WORD_1 dst_unused:UNUSED_PRESERVE src0_sel:WORD_0
    v_exp_f16_sdwa v134, v45 dst_sel:WORD_1 dst_unused:UNUSED_PRESERVE src0_sel:WORD_0
    v_exp_f16_sdwa v135, v47 dst_sel:WORD_1 dst_unused:UNUSED_PRESERVE src0_sel:WORD_0
    v_mfma_f32_32x32x16_f16 v[184:199], v[154:157], v[140:143], v[184:199]
    s_waitcnt lgkmcnt(0)
    v_exp_f16 v140, v56
    v_exp_f16 v141, v58
    v_exp_f16 v142, v60
    v_exp_f16 v143, v62
    v_exp_f16_sdwa v140, v57 dst_sel:WORD_1 dst_unused:UNUSED_PRESERVE src0_sel:WORD_0
    v_exp_f16_sdwa v141, v59 dst_sel:WORD_1 dst_unused:UNUSED_PRESERVE src0_sel:WORD_0
    v_exp_f16_sdwa v142, v61 dst_sel:WORD_1 dst_unused:UNUSED_PRESERVE src0_sel:WORD_0
    v_exp_f16_sdwa v143, v63 dst_sel:WORD_1 dst_unused:UNUSED_PRESERVE src0_sel:WORD_0
    v_mfma_f32_32x32x16_f16 v[96:111], v[28:31], v[128:131], v[96:111]
    ds_read_b128 v[16:19], v2 offset:5632
    v_exp_f16 v128, v64
    v_exp_f16 v129, v66
    v_exp_f16 v130, v68
    v_mfma_f32_32x32x16_bf16 v[32:47], v[20:23], v[144:147], 0
    ds_read_b128 v[24:27], v4 offset:4864
    v_exp_f16 v131, v70
    v_exp_f16_sdwa v128, v65 dst_sel:WORD_1 dst_unused:UNUSED_PRESERVE src0_sel:WORD_0
    v_exp_f16_sdwa v129, v67 dst_sel:WORD_1 dst_unused:UNUSED_PRESERVE src0_sel:WORD_0
    v_mfma_f32_32x32x16_f16 v[112:127], v[28:31], v[136:139], v[112:127]
    s_add_u32 s26, s26, 1
    v_exp_f16_sdwa v130, v69 dst_sel:WORD_1 dst_unused:UNUSED_PRESERVE src0_sel:WORD_0
    v_exp_f16_sdwa v131, v71 dst_sel:WORD_1 dst_unused:UNUSED_PRESERVE src0_sel:WORD_0
    v_exp_f16 v136, v80
    v_mfma_f32_32x32x16_bf16 v[48:63], v[20:23], v[148:151], 0
    s_cmp_lt_u32 s26, s34
    v_exp_f16 v137, v82
    v_exp_f16 v138, v84
    v_exp_f16 v139, v86
    v_mfma_f32_32x32x16_f16 v[96:111], v[158:161], v[132:135], v[96:111]
    v_exp_f16_sdwa v136, v81 dst_sel:WORD_1 dst_unused:UNUSED_PRESERVE src0_sel:WORD_0
    v_exp_f16_sdwa v137, v83 dst_sel:WORD_1 dst_unused:UNUSED_PRESERVE src0_sel:WORD_0
    v_exp_f16_sdwa v138, v85 dst_sel:WORD_1 dst_unused:UNUSED_PRESERVE src0_sel:WORD_0
    v_exp_f16_sdwa v139, v87 dst_sel:WORD_1 dst_unused:UNUSED_PRESERVE src0_sel:WORD_0
    v_mfma_f32_32x32x4_2b_bf16 v[32:63], v[162:163], v[152:153], v[32:63] cbsz:1 abid:0
    v_exp_f16 v132, v72
    v_exp_f16 v133, v74
    v_exp_f16 v134, v76
    v_exp_f16 v135, v78
    v_exp_f16_sdwa v132, v73 dst_sel:WORD_1 dst_unused:UNUSED_PRESERVE src0_sel:WORD_0
    v_exp_f16_sdwa v133, v75 dst_sel:WORD_1 dst_unused:UNUSED_PRESERVE src0_sel:WORD_0
    v_exp_f16_sdwa v134, v77 dst_sel:WORD_1 dst_unused:UNUSED_PRESERVE src0_sel:WORD_0
    v_exp_f16_sdwa v135, v79 dst_sel:WORD_1 dst_unused:UNUSED_PRESERVE src0_sel:WORD_0
    v_mfma_f32_32x32x16_f16 v[112:127], v[158:161], v[140:143], v[112:127]
    v_exp_f16 v140, v88
    v_exp_f16 v141, v90
    v_exp_f16 v142, v92
    v_exp_f16 v143, v94
    v_exp_f16_sdwa v140, v89 dst_sel:WORD_1 dst_unused:UNUSED_PRESERVE src0_sel:WORD_0
    v_exp_f16_sdwa v141, v91 dst_sel:WORD_1 dst_unused:UNUSED_PRESERVE src0_sel:WORD_0
    v_exp_f16_sdwa v142, v93 dst_sel:WORD_1 dst_unused:UNUSED_PRESERVE src0_sel:WORD_0
    v_exp_f16_sdwa v143, v95 dst_sel:WORD_1 dst_unused:UNUSED_PRESERVE src0_sel:WORD_0
    v_add_u32 v2, 4608, v2
    v_add_u32 v3, 4608, v3
    v_add_u32 v4, 4864, v4
    s_cbranch_scc1 L_loop
    s_cmp_eq_u32 s26, 16
    s_cbranch_scc1 L_last
    s_branch L_poll2
L_poll:
    ds_read_b32 v13, v8
    s_waitcnt lgkmcnt(0)
L_poll2:
    v_cmp_eq_u32 vcc, 0, v13
    s_nop 1
    s_ff1_i32_b32 s3, vcc_lo
    s_sub_u32 s3, s3, 1
    s_lshr_b32 s3, s3, 1
    s_min_u32 s34, s3, 16
    s_cmp_gt_u32 s34, s26
    s_cbranch_scc1 L_loop
    s_sleep 1
    s_branch L_poll
L_last:
    s_waitcnt lgkmcnt(0)
    v_mfma_f32_32x32x16_f16 v[168:183], v[28:31], v[128:131], v[168:183]
    v_mfma_f32_32x32x16_f16 v[184:199], v[28:31], v[136:139], v[184:199]
    v_mfma_f32_32x32x16_f16 v[168:183], v[158:161], v[132:135], v[168:183]
    v_mfma_f32_32x32x16_f16 v[184:199], v[158:161], v[140:143], v[184:199]
    v_mov_b32 v18, 0x207
    s_add_u32 s3, s37, 153088
    v_add_u32 v2, s3, v5
    v_add_u32 v3, s3, v6
    v_add_u32 v4, s3, v7
    v_permlane32_swap_b32 v96, v112
    v_permlane32_swap_b32 v97, v113
    v_permlane32_swap_b32 v98, v114
    v_permlane32_swap_b32 v99, v115
    v_permlane32_swap_b32 v100, v116
    v_permlane32_swap_b32 v101, v117
    v_permlane32_swap_b32 v102, v118
    v_permlane32_swap_b32 v103, v119
    v_permlane32_swap_b32 v104, v120
    v_permlane32_swap_b32 v105, v121
    v_permlane32_swap_b32 v106, v122
    s_nop 0
    v_rcp_f32 v16, v106
    s_nop 0
    v_add_f32 v16, v16, v15
    v_pk_mul_f32 v[96:97], v[96:97], v[16:17] op_sel_hi:[1,0]
    v_pk_mul_f32 v[98:99], v[98:99], v[16:17] op_sel_hi:[1,0]
    v_pk_mul_f32 v[112:113], v[112:113], v[16:17] op_sel_hi:[1,0]
    v_pk_mul_f32 v[114:115], v[114:115], v[16:17] op_sel_hi:[1,0]
    v_pk_mul_f32 v[100:101], v[100:101], v[16:17] op_sel_hi:[1,0]
    v_pk_mul_f32 v[102:103], v[102:103], v[16:17] op_sel_hi:[1,0]
    v_pk_mul_f32 v[116:117], v[116:117], v[16:17] op_sel_hi:[1,0]
    v_pk_mul_f32 v[118:119], v[118:119], v[16:17] op_sel_hi:[1,0]
    v_pk_mul_f32 v[104:105], v[104:105], v[16:17] op_sel_hi:[1,0]
    v_cvt_pk_bf16_f32 v20, v96, v97
    v_cvt_pk_bf16_f32 v21, v98, v99
    v_cvt_pk_bf16_f32 v22, v112, v113
    v_cvt_pk_bf16_f32 v23, v114, v115
    v_cvt_pk_bf16_f32 v24, v100, v101
    v_cvt_pk_bf16_f32 v25, v102, v103
    v_cvt_pk_bf16_f32 v26, v116, v117
    v_cvt_pk_bf16_f32 v27, v118, v119
    v_cvt_pk_bf16_f32 v28, v104, v105
    ds_write2_b32 v2, v20, v21 offset0:0 offset1:1
    ds_write2_b32 v2, v22, v23 offset0:2 offset1:3
    ds_write2_b32 v2, v24, v25 offset0:4 offset1:5
    ds_write2_b32 v2, v26, v27 offset0:6 offset1:7
    ds_write_b32 v2, v28 offset:32
    ds_read_b128 v[32:35], v3
    ds_read_b128 v[36:39], v3 offset:1024
    ds_read_b32 v40, v4 offset:2048
    v_pk_add_f32 v[96:97], v[96:97], v[100:101]
    v_pk_add_f32 v[98:99], v[98:99], v[102:103]
    v_pk_add_f32 v[112:113], v[112:113], v[116:117]
    v_pk_add_f32 v[114:115], v[114:115], v[118:119]
    v_pk_add_f32 v[96:97], v[96:97], v[112:113]
    v_pk_add_f32 v[98:99], v[98:99], v[114:115]
    v_pk_add_f32 v[96:97], v[96:97], v[98:99]
    v_pk_add_f32 v[96:97], v[96:97], v[104:105]
    v_add_f32 v17, v96, v97
    v_cmp_class_f32 vcc, v17, v18
    s_nop 1
    s_cmp_lg_u64 vcc, 0
    s_cbranch_scc1 L_slow
    s_nop 1
    v_permlane32_swap_b32 v168, v184
    v_permlane32_swap_b32 v169, v185
    v_permlane32_swap_b32 v170, v186
    v_permlane32_swap_b32 v171, v187
    v_permlane32_swap_b32 v172, v188
    v_permlane32_swap_b32 v173, v189
    v_permlane32_swap_b32 v174, v190
    v_permlane32_swap_b32 v175, v191
    v_permlane32_swap_b32 v176, v192
    v_permlane32_swap_b32 v177, v193
    v_permlane32_swap_b32 v178, v194
    s_nop 0
    v_rcp_f32 v16, v178
    s_nop 0
    v_add_f32 v16, v16, v9
    v_pk_mul_f32 v[168:169], v[168:169], v[16:17] op_sel_hi:[1,0]
    v_pk_mul_f32 v[170:171], v[170:171], v[16:17] op_sel_hi:[1,0]
    v_pk_mul_f32 v[184:185], v[184:185], v[16:17] op_sel_hi:[1,0]
    v_pk_mul_f32 v[186:187], v[186:187], v[16:17] op_sel_hi:[1,0]
    v_pk_mul_f32 v[172:173], v[172:173], v[16:17] op_sel_hi:[1,0]
    v_pk_mul_f32 v[174:175], v[174:175], v[16:17] op_sel_hi:[1,0]
    v_pk_mul_f32 v[188:189], v[188:189], v[16:17] op_sel_hi:[1,0]
    v_pk_mul_f32 v[190:191], v[190:191], v[16:17] op_sel_hi:[1,0]
    v_pk_mul_f32 v[176:177], v[176:177], v[16:17] op_sel_hi:[1,0]
    v_cvt_pk_bf16_f32 v20, v168, v169
    v_cvt_pk_bf16_f32 v21, v170, v171
    v_cvt_pk_bf16_f32 v22, v184, v185
    v_cvt_pk_bf16_f32 v23, v186, v187
    v_cvt_pk_bf16_f32 v24, v172, v173
    v_cvt_pk_bf16_f32 v25, v174, v175
    v_cvt_pk_bf16_f32 v26, v188, v189
    v_cvt_pk_bf16_f32 v27, v190, v191
    v_cvt_pk_bf16_f32 v28, v176, v177
    s_waitcnt lgkmcnt(0)
    buffer_store_dwordx4 v[32:35], v6, s[20:23], s32 offen nt
    buffer_store_dwordx4 v[36:39], v6, s[20:23], s32 offen offset:1024 nt
    buffer_store_dword v40, v7, s[20:23], s32 offen offset:2048 nt
    ds_write2_b32 v2, v20, v21 offset0:0 offset1:1
    ds_write2_b32 v2, v22, v23 offset0:2 offset1:3
    ds_write2_b32 v2, v24, v25 offset0:4 offset1:5
    ds_write2_b32 v2, v26, v27 offset0:6 offset1:7
    ds_write_b32 v2, v28 offset:32
    ds_read_b128 v[44:47], v3
    ds_read_b128 v[48:51], v3 offset:1024
    ds_read_b32 v52, v4 offset:2048
    v_pk_add_f32 v[168:169], v[168:169], v[172:173]
    v_pk_add_f32 v[170:171], v[170:171], v[174:175]
    v_pk_add_f32 v[184:185], v[184:185], v[188:189]
    v_pk_add_f32 v[186:187], v[186:187], v[190:191]
    v_pk_add_f32 v[168:169], v[168:169], v[184:185]
    v_pk_add_f32 v[170:171], v[170:171], v[186:187]
    v_pk_add_f32 v[168:169], v[168:169], v[170:171]
    v_pk_add_f32 v[168:169], v[168:169], v[176:177]
    v_add_f32 v17, v168, v169
    v_cmp_class_f32 vcc, v17, v18
    s_nop 1
    s_cmp_lg_u64 vcc, 0
    s_cbranch_scc1 L_slow
    s_waitcnt lgkmcnt(0)
    buffer_store_dwordx4 v[44:47], v6, s[20:23], s61 offen nt
    buffer_store_dwordx4 v[48:51], v6, s[20:23], s61 offen offset:1024 nt
    buffer_store_dword v52, v7, s[20:23], s61 offen offset:2048 nt
L_fin:
L_end:
    s_endpgm
L_slow:
    s_setprio 0
    s_waitcnt vmcnt(0) lgkmcnt(0)
    s_mov_b32 s34, s32
L_s0:
    v_mov_b32 v27, 0x3fb8aa3b
    v_mul_f32 v27, s29, v27
    buffer_load_dwordx4 v[32:35], v5, s[8:11], s34 offen
    buffer_load_dwordx4 v[36:39], v5, s[8:11], s34 offen offset:16
    buffer_load_dword v40, v5, s[8:11], s34 offen offset:32
    v_readfirstlane_b32 s27, v27
    v_and_b32 v17, 31, v1
    v_lshrrev_b32 v18, 5, v1
    v_lshlrev_b32 v19, 3, v18
    v_sub_u32 v19, v17, v19
    v_mov_b32 v20, 0x3f80
    v_mov_b32 v21, 0x3f800000
    v_cmp_eq_u32 vcc, 0, v19
    v_cmp_eq_u32 s[52:53], 1, v19
    s_nop 0
    v_cndmask_b32 v84, 0, v20, vcc
    v_cndmask_b32 v84, v84, v21, s[52:53]
    v_cmp_eq_u32 vcc, 2, v19
    v_cmp_eq_u32 s[52:53], 3, v19
    s_nop 0
    v_cndmask_b32 v85, 0, v20, vcc
    v_cndmask_b32 v85, v85, v21, s[52:53]
    v_cmp_eq_u32 vcc, 4, v19
    v_cmp_eq_u32 s[52:53], 5, v19
    s_nop 0
    v_cndmask_b32 v86, 0, v20, vcc
    v_cndmask_b32 v86, v86, v21, s[52:53]
    v_cmp_eq_u32 vcc, 6, v19
    v_cmp_eq_u32 s[52:53], 7, v19
    s_nop 0
    v_cndmask_b32 v87, 0, v20, vcc
    v_cndmask_b32 v87, v87, v21, s[52:53]
    v_cmp_eq_u32 vcc, 16, v17
    v_cmp_eq_u32 s[52:53], 17, v17
    v_cmp_eq_u32 s[54:55], 18, v17
    v_cndmask_b32 v88, 0, v20, vcc
    v_cndmask_b32 v88, v88, v21, s[52:53]
    v_cndmask_b32 v89, 0, v20, s[54:55]
    v_mul_u32_u24 v3, 36, v17
    v_lshl_add_u32 v3, v18, 4, v3
    s_waitcnt vmcnt(0)
    v_mov_b32 v10, 0
    v_mov_b32 v11, 0
    v_dot2c_f32_bf16 v10, v32, v32
    v_dot2c_f32_bf16 v11, v33, v33
    v_dot2c_f32_bf16 v10, v34, v34
    v_dot2c_f32_bf16 v11, v35, v35
    v_dot2c_f32_bf16 v10, v36, v36
    v_dot2c_f32_bf16 v11, v37, v37
    v_dot2c_f32_bf16 v10, v38, v38
    v_dot2c_f32_bf16 v11, v39, v39
    v_dot2c_f32_bf16 v10, v40, v40
    v_lshlrev_b32 v16, 16, v32
    v_and_b32 v17, 0xffff0000, v32
    v_lshlrev_b32 v18, 16, v33
    v_and_b32 v19, 0xffff0000, v33
    v_lshlrev_b32 v20, 16, v34
    v_and_b32 v21, 0xffff0000, v34
    v_lshlrev_b32 v22, 16, v35
    v_and_b32 v23, 0xffff0000, v35
    v_lshlrev_b32 v24, 16, v36
    v_and_b32 v25, 0xffff0000, v36
    v_lshlrev_b32 v26, 16, v37
    v_and_b32 v27, 0xffff0000, v37
    v_lshlrev_b32 v28, 16, v38
    v_and_b32 v29, 0xffff0000, v38
    v_lshlrev_b32 v30, 16, v39
    v_and_b32 v31, 0xffff0000, v39
    v_add_f32 v10, v10, v11
    v_sqrt_f32 v12, v10
    v_sub_f32 v15, v10, v10
    v_add_f32 v12, 0x358637bd, v12
    v_rcp_f32 v12, v12
    v_lshlrev_b32 v10, 16, v40
    v_and_b32 v11, 0xffff0000, v40
    v_mul_f32 v12, s27, v12
    v_pk_mul_f32 v[16:17], v[16:17], v[12:13] op_sel_hi:[1,0]
    v_pk_mul_f32 v[18:19], v[18:19], v[12:13] op_sel_hi:[1,0]
    v_pk_mul_f32 v[20:21], v[20:21], v[12:13] op_sel_hi:[1,0]
    v_pk_mul_f32 v[22:23], v[22:23], v[12:13] op_sel_hi:[1,0]
    v_pk_mul_f32 v[24:25], v[24:25], v[12:13] op_sel_hi:[1,0]
    v_pk_mul_f32 v[26:27], v[26:27], v[12:13] op_sel_hi:[1,0]
    v_pk_mul_f32 v[28:29], v[28:29], v[12:13] op_sel_hi:[1,0]
    v_pk_mul_f32 v[30:31], v[30:31], v[12:13] op_sel_hi:[1,0]
    v_pk_mul_f32 v[10:11], v[10:11], v[12:13] op_sel_hi:[1,0]
    v_cvt_pk_bf16_f32 v144, v16, v17
    v_cvt_pk_bf16_f32 v145, v18, v19
    v_cvt_pk_bf16_f32 v146, v20, v21
    v_cvt_pk_bf16_f32 v147, v22, v23
    v_cvt_pk_bf16_f32 v148, v24, v25
    v_cvt_pk_bf16_f32 v149, v26, v27
    v_cvt_pk_bf16_f32 v150, v28, v29
    v_cvt_pk_bf16_f32 v151, v30, v31
    v_cvt_pk_bf16_f32 v152, v10, v11
    s_nop 0
    v_permlane32_swap_b32 v144, v148
    v_permlane32_swap_b32 v145, v149
    v_permlane32_swap_b32 v146, v150
    v_permlane32_swap_b32 v147, v151
    v_mov_b32 v153, 0
    v_mov_b32 v15, 0
    v_mov_b32 v73, 0
    v_mov_b32 v83, 0x3f80
    v_mov_b32 v90, 0xff800000
    v_mov_b32 v91, 0xff800000
    v_mov_b32 v96, 0
    v_mov_b32 v97, 0
    v_mov_b32 v98, 0
    v_mov_b32 v99, 0
    v_mov_b32 v100, 0
    v_mov_b32 v101, 0
    v_mov_b32 v102, 0
    v_mov_b32 v103, 0
    v_mov_b32 v104, 0
    v_mov_b32 v105, 0
    v_mov_b32 v106, 0
    v_mov_b32 v107, 0
    v_mov_b32 v108, 0
    v_mov_b32 v109, 0
    v_mov_b32 v110, 0
    v_mov_b32 v111, 0
    v_mov_b32 v112, 0
    v_mov_b32 v113, 0
    v_mov_b32 v114, 0
    v_mov_b32 v115, 0
    v_mov_b32 v116, 0
    v_mov_b32 v117, 0
    v_mov_b32 v118, 0
    v_mov_b32 v119, 0
    v_mov_b32 v120, 0
    v_mov_b32 v121, 0
    v_mov_b32 v122, 0
    v_mov_b32 v123, 0
    v_mov_b32 v124, 0
    v_mov_b32 v125, 0
    v_mov_b32 v126, 0
    v_mov_b32 v127, 0
    s_mov_b32 s39, s33
    s_mov_b32 s26, 0
L_s1:
    buffer_load_dwordx4 v[64:67], v5, s[12:15], s39 offen
    buffer_load_dwordx4 v[68:71], v5, s[12:15], s39 offen offset:16
    buffer_load_dword v72, v5, s[12:15], s39 offen offset:32
    s_waitcnt vmcnt(0)
    v_mov_b32 v10, 0
    v_mov_b32 v11, 0
    v_dot2c_f32_bf16 v10, v64, v64
    v_dot2c_f32_bf16 v11, v65, v65
    v_dot2c_f32_bf16 v10, v66, v66
    v_dot2c_f32_bf16 v11, v67, v67
    v_dot2c_f32_bf16 v10, v68, v68
    v_dot2c_f32_bf16 v11, v69, v69
    v_dot2c_f32_bf16 v10, v70, v70
    v_dot2c_f32_bf16 v11, v71, v71
    v_dot2c_f32_bf16 v10, v72, v72
    v_lshlrev_b32 v16, 16, v64
    v_and_b32 v17, 0xffff0000, v64
    v_lshlrev_b32 v18, 16, v65
    v_and_b32 v19, 0xffff0000, v65
    v_lshlrev_b32 v20, 16, v66
    v_and_b32 v21, 0xffff0000, v66
    v_lshlrev_b32 v22, 16, v67
    v_and_b32 v23, 0xffff0000, v67
    v_lshlrev_b32 v24, 16, v68
    v_and_b32 v25, 0xffff0000, v68
    v_lshlrev_b32 v26, 16, v69
    v_and_b32 v27, 0xffff0000, v69
    v_lshlrev_b32 v28, 16, v70
    v_and_b32 v29, 0xffff0000, v70
    v_lshlrev_b32 v30, 16, v71
    v_and_b32 v31, 0xffff0000, v71
    v_add_f32 v10, v10, v11
    v_sqrt_f32 v12, v10
    s_nop 0
    v_add_f32 v12, 0x358637bd, v12
    v_rcp_f32 v12, v12
    v_lshlrev_b32 v10, 16, v72
    v_and_b32 v11, 0xffff0000, v72
    v_pk_mul_f32 v[16:17], v[16:17], v[12:13] op_sel_hi:[1,0]
    v_pk_mul_f32 v[18:19], v[18:19], v[12:13] op_sel_hi:[1,0]
    v_pk_mul_f32 v[20:21], v[20:21], v[12:13] op_sel_hi:[1,0]
    v_pk_mul_f32 v[22:23], v[22:23], v[12:13] op_sel_hi:[1,0]
    v_pk_mul_f32 v[24:25], v[24:25], v[12:13] op_sel_hi:[1,0]
    v_pk_mul_f32 v[26:27], v[26:27], v[12:13] op_sel_hi:[1,0]
    v_pk_mul_f32 v[28:29], v[28:29], v[12:13] op_sel_hi:[1,0]
    v_pk_mul_f32 v[30:31], v[30:31], v[12:13] op_sel_hi:[1,0]
    v_pk_mul_f32 v[10:11], v[10:11], v[12:13] op_sel_hi:[1,0]
    v_cvt_pk_bf16_f32 v64, v16, v17
    v_cvt_pk_bf16_f32 v65, v18, v19
    v_cvt_pk_bf16_f32 v66, v20, v21
    v_cvt_pk_bf16_f32 v67, v22, v23
    v_cvt_pk_bf16_f32 v68, v24, v25
    v_cvt_pk_bf16_f32 v69, v26, v27
    v_cvt_pk_bf16_f32 v70, v28, v29
    v_cvt_pk_bf16_f32 v71, v30, v31
    v_cvt_pk_bf16_f32 v72, v10, v11
    s_nop 1
    v_permlane32_swap_b32 v64, v68
    v_permlane32_swap_b32 v65, v69
    v_permlane32_swap_b32 v66, v70
    v_permlane32_swap_b32 v67, v71
    s_nop 1
    v_mfma_f32_32x32x16_bf16 v[32:47], v[64:67], v[144:147], 0
    v_mfma_f32_32x32x16_bf16 v[48:63], v[64:67], v[148:151], 0
    s_nop 10
    v_mfma_f32_32x32x4_2b_bf16 v[32:63], v[72:73], v[152:153], v[32:63] cbsz:1 abid:0
    s_nop 15
    s_nop 4
    v_max3_f32 v90, v32, v33, v90
    v_max3_f32 v91, v48, v49, v91
    v_max3_f32 v90, v34, v35, v90
    v_max3_f32 v91, v50, v51, v91
    v_max3_f32 v90, v36, v37, v90
    v_max3_f32 v91, v52, v53, v91
    v_max3_f32 v90, v38, v39, v90
    v_max3_f32 v91, v54, v55, v91
    v_max3_f32 v90, v40, v41, v90
    v_max3_f32 v91, v56, v57, v91
    v_max3_f32 v90, v42, v43, v90
    v_max3_f32 v91, v58, v59, v91
    v_max3_f32 v90, v44, v45, v90
    v_max3_f32 v91, v60, v61, v91
    v_max3_f32 v90, v46, v47, v90
    v_max3_f32 v91, v62, v63, v91
    v_mfma_f32_32x32x16_bf16 v[32:47], v[68:71], v[144:147], 0
    v_mfma_f32_32x32x16_bf16 v[48:63], v[68:71], v[148:151], 0
    s_nop 10
    v_mfma_f32_32x32x4_2b_bf16 v[32:63], v[72:73], v[152:153], v[32:63] cbsz:1 abid:1
    s_nop 15
    s_nop 4
    v_max3_f32 v90, v32, v33, v90
    v_max3_f32 v91, v48, v49, v91
    v_max3_f32 v90, v34, v35, v90
    v_max3_f32 v91, v50, v51, v91
    v_max3_f32 v90, v36, v37, v90
    v_max3_f32 v91, v52, v53, v91
    v_max3_f32 v90, v38, v39, v90
    v_max3_f32 v91, v54, v55, v91
    v_max3_f32 v90, v40, v41, v90
    v_max3_f32 v91, v56, v57, v91
    v_max3_f32 v90, v42, v43, v90
    v_max3_f32 v91, v58, v59, v91
    v_max3_f32 v90, v44, v45, v90
    v_max3_f32 v91, v60, v61, v91
    v_max3_f32 v90, v46, v47, v90
    v_max3_f32 v91, v62, v63, v91
    s_add_u32 s39, s39, 2304
    s_add_u32 s26, s26, 1
    s_cmp_lt_u32 s26, 32
    s_cbranch_scc1 L_s1
    v_mov_b32 v16, v90
    v_mov_b32 v17, v90
    s_nop 1
    v_permlane32_swap_b32 v16, v17
    s_nop 1
    v_max_f32 v90, v16, v17
    v_mov_b32 v16, v91
    v_mov_b32 v17, v91
    s_nop 1
    v_permlane32_swap_b32 v16, v17
    s_nop 1
    v_max_f32 v91, v16, v17
    s_mov_b32 s39, s33
    s_mov_b32 s26, 0
L_s2:
    buffer_load_dwordx4 v[64:67], v5, s[12:15], s39 offen
    buffer_load_dwordx4 v[68:71], v5, s[12:15], s39 offen offset:16
    buffer_load_dword v72, v5, s[12:15], s39 offen offset:32
    buffer_load_dwordx4 v[74:77], v3, s[16:19], s39 offen
    buffer_load_dwordx4 v[78:81], v3, s[16:19], s39 offen offset:1152
    buffer_load_dword v82, v5, s[16:19], s39 offen offset:32
    s_waitcnt vmcnt(0)
    v_mfma_f32_32x32x16_bf16 v[32:47], v[74:77], v[84:87], 0
    v_mfma_f32_32x32x16_bf16 v[48:63], v[78:81], v[84:87], 0
    s_nop 10
    v_mfma_f32_32x32x4_2b_bf16 v[32:63], v[82:83], v[88:89], v[32:63]
    v_mov_b32 v10, 0
    v_mov_b32 v11, 0
    v_dot2c_f32_bf16 v10, v64, v64
    v_dot2c_f32_bf16 v11, v65, v65
    v_dot2c_f32_bf16 v10, v66, v66
    v_dot2c_f32_bf16 v11, v67, v67
    v_dot2c_f32_bf16 v10, v68, v68
    v_dot2c_f32_bf16 v11, v69, v69
    v_dot2c_f32_bf16 v10, v70, v70
    v_dot2c_f32_bf16 v11, v71, v71
    v_dot2c_f32_bf16 v10, v72, v72
    v_lshlrev_b32 v16, 16, v64
    v_and_b32 v17, 0xffff0000, v64
    v_lshlrev_b32 v18, 16, v65
    v_and_b32 v19, 0xffff0000, v65
    v_lshlrev_b32 v20, 16, v66
    v_and_b32 v21, 0xffff0000, v66
    v_lshlrev_b32 v22, 16, v67
    v_and_b32 v23, 0xffff0000, v67
    v_lshlrev_b32 v24, 16, v68
    v_and_b32 v25, 0xffff0000, v68
    v_lshlrev_b32 v26, 16, v69
    v_and_b32 v27, 0xffff0000, v69
    v_lshlrev_b32 v28, 16, v70
    v_and_b32 v29, 0xffff0000, v70
    v_lshlrev_b32 v30, 16, v71
    v_and_b32 v31, 0xffff0000, v71
    v_add_f32 v10, v10, v11
    v_sqrt_f32 v12, v10
    s_nop 0
    v_add_f32 v12, 0x358637bd, v12
    v_rcp_f32 v12, v12
    v_lshlrev_b32 v10, 16, v72
    v_and_b32 v11, 0xffff0000, v72
    v_pk_mul_f32 v[16:17], v[16:17], v[12:13] op_sel_hi:[1,0]
    v_pk_mul_f32 v[18:19], v[18:19], v[12:13] op_sel_hi:[1,0]
    v_pk_mul_f32 v[20:21], v[20:21], v[12:13] op_sel_hi:[1,0]
    v_pk_mul_f32 v[22:23], v[22:23], v[12:13] op_sel_hi:[1,0]
    v_pk_mul_f32 v[24:25], v[24:25], v[12:13] op_sel_hi:[1,0]
    v_pk_mul_f32 v[26:27], v[26:27], v[12:13] op_sel_hi:[1,0]
    v_pk_mul_f32 v[28:29], v[28:29], v[12:13] op_sel_hi:[1,0]
    v_pk_mul_f32 v[30:31], v[30:31], v[12:13] op_sel_hi:[1,0]
    v_pk_mul_f32 v[10:11], v[10:11], v[12:13] op_sel_hi:[1,0]
    v_cvt_pk_bf16_f32 v64, v16, v17
    v_cvt_pk_bf16_f32 v65, v18, v19
    v_cvt_pk_bf16_f32 v66, v20, v21
    v_cvt_pk_bf16_f32 v67, v22, v23
    v_cvt_pk_bf16_f32 v68, v24, v25
    v_cvt_pk_bf16_f32 v69, v26, v27
    v_cvt_pk_bf16_f32 v70, v28, v29
    v_cvt_pk_bf16_f32 v71, v30, v31
    v_cvt_pk_bf16_f32 v72, v10, v11
    s_nop 1
    v_permlane32_swap_b32 v64, v68
    v_permlane32_swap_b32 v65, v69
    v_permlane32_swap_b32 v66, v70
    v_permlane32_swap_b32 v67, v71
    s_nop 1
    v_cvt_pk_bf16_f32 v154, v32, v33
    v_cvt_pk_bf16_f32 v155, v34, v35
    v_cvt_pk_bf16_f32 v156, v36, v37
    v_cvt_pk_bf16_f32 v157, v38, v39
    v_cvt_pk_bf16_f32 v158, v40, v41
    v_cvt_pk_bf16_f32 v159, v42, v43
    v_cvt_pk_bf16_f32 v160, v44, v45
    v_cvt_pk_bf16_f32 v161, v46, v47
    v_cvt_pk_bf16_f32 v92, v48, v49
    v_cvt_pk_bf16_f32 v93, v50, v51
    v_cvt_pk_bf16_f32 v94, v52, v53
    v_cvt_pk_bf16_f32 v95, v54, v55
    v_cvt_pk_bf16_f32 v162, v56, v57
    v_cvt_pk_bf16_f32 v163, v58, v59
    v_cvt_pk_bf16_f32 v164, v60, v61
    v_cvt_pk_bf16_f32 v165, v62, v63
    v_mfma_f32_32x32x16_bf16 v[32:47], v[64:67], v[144:147], 0
    v_mfma_f32_32x32x16_bf16 v[48:63], v[64:67], v[148:151], 0
    s_nop 10
    v_mfma_f32_32x32x4_2b_bf16 v[32:63], v[72:73], v[152:153], v[32:63] cbsz:1 abid:0
    s_nop 15
    s_nop 4
    v_sub_f32 v32, v32, v90
    v_sub_f32 v33, v33, v90
    v_sub_f32 v34, v34, v90
    v_sub_f32 v35, v35, v90
    v_sub_f32 v36, v36, v90
    v_sub_f32 v37, v37, v90
    v_sub_f32 v38, v38, v90
    v_sub_f32 v39, v39, v90
    v_sub_f32 v40, v40, v90
    v_sub_f32 v41, v41, v90
    v_sub_f32 v42, v42, v90
    v_sub_f32 v43, v43, v90
    v_sub_f32 v44, v44, v90
    v_sub_f32 v45, v45, v90
    v_sub_f32 v46, v46, v90
    v_sub_f32 v47, v47, v90
    v_sub_f32 v48, v48, v91
    v_sub_f32 v49, v49, v91
    v_sub_f32 v50, v50, v91
    v_sub_f32 v51, v51, v91
    v_sub_f32 v52, v52, v91
    v_sub_f32 v53, v53, v91
    v_sub_f32 v54, v54, v91
    v_sub_f32 v55, v55, v91
    v_sub_f32 v56, v56, v91
    v_sub_f32 v57, v57, v91
    v_sub_f32 v58, v58, v91
    v_sub_f32 v59, v59, v91
    v_sub_f32 v60, v60, v91
    v_sub_f32 v61, v61, v91
    v_sub_f32 v62, v62, v91
    v_sub_f32 v63, v63, v91
    v_exp_f32 v32, v32
    v_exp_f32 v33, v33
    v_exp_f32 v34, v34
    v_exp_f32 v35, v35
    v_exp_f32 v36, v36
    v_exp_f32 v37, v37
    v_exp_f32 v38, v38
    v_exp_f32 v39, v39
    v_exp_f32 v40, v40
    v_exp_f32 v41, v41
    v_exp_f32 v42, v42
    v_exp_f32 v43, v43
    v_exp_f32 v44, v44
    v_exp_f32 v45, v45
    v_exp_f32 v46, v46
    v_exp_f32 v47, v47
    v_exp_f32 v48, v48
    v_exp_f32 v49, v49
    v_exp_f32 v50, v50
    v_exp_f32 v51, v51
    v_exp_f32 v52, v52
    v_exp_f32 v53, v53
    v_exp_f32 v54, v54
    v_exp_f32 v55, v55
    v_exp_f32 v56, v56
    v_exp_f32 v57, v57
    v_exp_f32 v58, v58
    v_exp_f32 v59, v59
    v_exp_f32 v60, v60
    v_exp_f32 v61, v61
    v_exp_f32 v62, v62
    v_exp_f32 v63, v63
    s_nop 0
    v_cvt_pk_bf16_f32 v128, v32, v33
    v_cvt_pk_bf16_f32 v129, v34, v35
    v_cvt_pk_bf16_f32 v130, v36, v37
    v_cvt_pk_bf16_f32 v131, v38, v39
    v_cvt_pk_bf16_f32 v132, v40, v41
    v_cvt_pk_bf16_f32 v133, v42, v43
    v_cvt_pk_bf16_f32 v134, v44, v45
    v_cvt_pk_bf16_f32 v135, v46, v47
    v_cvt_pk_bf16_f32 v136, v48, v49
    v_cvt_pk_bf16_f32 v137, v50, v51
    v_cvt_pk_bf16_f32 v138, v52, v53
    v_cvt_pk_bf16_f32 v139, v54, v55
    v_cvt_pk_bf16_f32 v140, v56, v57
    v_cvt_pk_bf16_f32 v141, v58, v59
    v_cvt_pk_bf16_f32 v142, v60, v61
    v_cvt_pk_bf16_f32 v143, v62, v63
    s_nop 1
    v_mfma_f32_32x32x16_bf16 v[96:111], v[154:157], v[128:131], v[96:111]
    v_mfma_f32_32x32x16_bf16 v[112:127], v[154:157], v[136:139], v[112:127]
    v_mfma_f32_32x32x16_bf16 v[96:111], v[158:161], v[132:135], v[96:111]
    v_mfma_f32_32x32x16_bf16 v[112:127], v[158:161], v[140:143], v[112:127]
    v_mfma_f32_32x32x16_bf16 v[32:47], v[68:71], v[144:147], 0
    v_mfma_f32_32x32x16_bf16 v[48:63], v[68:71], v[148:151], 0
    s_nop 10
    v_mfma_f32_32x32x4_2b_bf16 v[32:63], v[72:73], v[152:153], v[32:63] cbsz:1 abid:1
    s_nop 15
    s_nop 4
    v_sub_f32 v32, v32, v90
    v_sub_f32 v33, v33, v90
    v_sub_f32 v34, v34, v90
    v_sub_f32 v35, v35, v90
    v_sub_f32 v36, v36, v90
    v_sub_f32 v37, v37, v90
    v_sub_f32 v38, v38, v90
    v_sub_f32 v39, v39, v90
    v_sub_f32 v40, v40, v90
    v_sub_f32 v41, v41, v90
    v_sub_f32 v42, v42, v90
    v_sub_f32 v43, v43, v90
    v_sub_f32 v44, v44, v90
    v_sub_f32 v45, v45, v90
    v_sub_f32 v46, v46, v90
    v_sub_f32 v47, v47, v90
    v_sub_f32 v48, v48, v91
    v_sub_f32 v49, v49, v91
    v_sub_f32 v50, v50, v91
    v_sub_f32 v51, v51, v91
    v_sub_f32 v52, v52, v91
    v_sub_f32 v53, v53, v91
    v_sub_f32 v54, v54, v91
    v_sub_f32 v55, v55, v91
    v_sub_f32 v56, v56, v91
    v_sub_f32 v57, v57, v91
    v_sub_f32 v58, v58, v91
    v_sub_f32 v59, v59, v91
    v_sub_f32 v60, v60, v91
    v_sub_f32 v61, v61, v91
    v_sub_f32 v62, v62, v91
    v_sub_f32 v63, v63, v91
    v_exp_f32 v32, v32
    v_exp_f32 v33, v33
    v_exp_f32 v34, v34
    v_exp_f32 v35, v35
    v_exp_f32 v36, v36
    v_exp_f32 v37, v37
    v_exp_f32 v38, v38
    v_exp_f32 v39, v39
    v_exp_f32 v40, v40
    v_exp_f32 v41, v41
    v_exp_f32 v42, v42
    v_exp_f32 v43, v43
    v_exp_f32 v44, v44
    v_exp_f32 v45, v45
    v_exp_f32 v46, v46
    v_exp_f32 v47, v47
    v_exp_f32 v48, v48
    v_exp_f32 v49, v49
    v_exp_f32 v50, v50
    v_exp_f32 v51, v51
    v_exp_f32 v52, v52
    v_exp_f32 v53, v53
    v_exp_f32 v54, v54
    v_exp_f32 v55, v55
    v_exp_f32 v56, v56
    v_exp_f32 v57, v57
    v_exp_f32 v58, v58
    v_exp_f32 v59, v59
    v_exp_f32 v60, v60
    v_exp_f32 v61, v61
    v_exp_f32 v62, v62
    v_exp_f32 v63, v63
    s_nop 0
    v_cvt_pk_bf16_f32 v128, v32, v33
    v_cvt_pk_bf16_f32 v129, v34, v35
    v_cvt_pk_bf16_f32 v130, v36, v37
    v_cvt_pk_bf16_f32 v131, v38, v39
    v_cvt_pk_bf16_f32 v132, v40, v41
    v_cvt_pk_bf16_f32 v133, v42, v43
    v_cvt_pk_bf16_f32 v134, v44, v45
    v_cvt_pk_bf16_f32 v135, v46, v47
    v_cvt_pk_bf16_f32 v136, v48, v49
    v_cvt_pk_bf16_f32 v137, v50, v51
    v_cvt_pk_bf16_f32 v138, v52, v53
    v_cvt_pk_bf16_f32 v139, v54, v55
    v_cvt_pk_bf16_f32 v140, v56, v57
    v_cvt_pk_bf16_f32 v141, v58, v59
    v_cvt_pk_bf16_f32 v142, v60, v61
    v_cvt_pk_bf16_f32 v143, v62, v63
    s_nop 1
    v_mfma_f32_32x32x16_bf16 v[96:111], v[92:95], v[128:131], v[96:111]
    v_mfma_f32_32x32x16_bf16 v[112:127], v[92:95], v[136:139], v[112:127]
    v_mfma_f32_32x32x16_bf16 v[96:111], v[162:165], v[132:135], v[96:111]
    v_mfma_f32_32x32x16_bf16 v[112:127], v[162:165], v[140:143], v[112:127]
    s_add_u32 s39, s39, 2304
    s_add_u32 s26, s26, 1
    s_cmp_lt_u32 s26, 32
    s_cbranch_scc1 L_s2
    s_nop 15
    v_permlane32_swap_b32 v96, v112
    v_permlane32_swap_b32 v97, v113
    v_permlane32_swap_b32 v98, v114
    v_permlane32_swap_b32 v99, v115
    v_permlane32_swap_b32 v100, v116
    v_permlane32_swap_b32 v101, v117
    v_permlane32_swap_b32 v102, v118
    v_permlane32_swap_b32 v103, v119
    v_permlane32_swap_b32 v104, v120
    v_permlane32_swap_b32 v105, v121
    v_permlane32_swap_b32 v106, v122
    s_nop 0
    v_rcp_f32 v16, v106
    s_nop 0
    v_pk_mul_f32 v[96:97], v[96:97], v[16:17] op_sel_hi:[1,0]
    v_pk_mul_f32 v[98:99], v[98:99], v[16:17] op_sel_hi:[1,0]
    v_pk_mul_f32 v[112:113], v[112:113], v[16:17] op_sel_hi:[1,0]
    v_pk_mul_f32 v[114:115], v[114:115], v[16:17] op_sel_hi:[1,0]
    v_pk_mul_f32 v[100:101], v[100:101], v[16:17] op_sel_hi:[1,0]
    v_pk_mul_f32 v[102:103], v[102:103], v[16:17] op_sel_hi:[1,0]
    v_pk_mul_f32 v[116:117], v[116:117], v[16:17] op_sel_hi:[1,0]
    v_pk_mul_f32 v[118:119], v[118:119], v[16:17] op_sel_hi:[1,0]
    v_pk_mul_f32 v[104:105], v[104:105], v[16:17] op_sel_hi:[1,0]
    v_cvt_pk_bf16_f32 v20, v96, v97
    v_cvt_pk_bf16_f32 v21, v98, v99
    v_cvt_pk_bf16_f32 v22, v112, v113
    v_cvt_pk_bf16_f32 v23, v114, v115
    v_cvt_pk_bf16_f32 v24, v100, v101
    v_cvt_pk_bf16_f32 v25, v102, v103
    v_cvt_pk_bf16_f32 v26, v116, v117
    v_cvt_pk_bf16_f32 v27, v118, v119
    v_cvt_pk_bf16_f32 v28, v104, v105
    buffer_store_dwordx4 v[20:23], v5, s[20:23], s34 offen
    buffer_store_dwordx4 v[24:27], v5, s[20:23], s34 offen offset:16
    buffer_store_dword v28, v5, s[20:23], s34 offen offset:32
    s_cmp_lg_u32 s34, s32
    s_cbranch_scc1 L_fin
    s_add_u32 s34, s32, 2304
    s_nop 1
    s_branch L_s0
.section .rodata,"a"
.p2align 6
.amdhsa_kernel standalone__qk_norm__prompt_kernel
  .amdhsa_next_free_vgpr 232
  .amdhsa_next_free_sgpr 96
  .amdhsa_accum_offset 232
  .amdhsa_group_segment_fixed_size 0
  .amdhsa_kernarg_size 56
  .amdhsa_user_sgpr_count 2
  .amdhsa_user_sgpr_kernarg_segment_ptr 1
  .amdhsa_system_sgpr_workgroup_id_x 1
.end_amdhsa_kernel
```
